```python
import torch

def _softmax(x, axis=-1):
    return torch.softmax(x, dim=axis)
def _gelu(x):
    return torch.nn.functional.gelu(x, approximate="tanh")
def _silu(x):
    return torch.nn.functional.silu(x)
def _sigmoid(x):
    return torch.sigmoid(x)
def _layernorm(x, axis=-1, eps=1e-5):
    m = x.mean(dim=axis, keepdim=True)
    v = x.var(dim=axis, keepdim=True, unbiased=False)
    return (x - m) / torch.sqrt(v + eps)
def _scatter_add(tgt, idx, src, axis=0):
    return tgt.clone().index_add_(axis, idx, src)
def _segment_sum(src, seg, n):
    out = torch.zeros((n,) + src.shape[1:], dtype=src.dtype)
    return out.index_add_(0, seg, src)
def _pad(x, pw):
    flat = tuple(v for pair in reversed(pw) for v in pair)
    return torch.nn.functional.pad(x, flat)

kernel_name = 'standalone__softmax_full_bidir__decode'

def setup_inputs():

    _w = (lambda a: (lambda t: t.to(torch.bfloat16) if t.is_floating_point() else t)(torch.as_tensor(a)))
    B, H, Sq, Skv, Dh = 4, 16, 1, 16384, 256
    return {
        "q": _w((lambda *s: torch.randn(*s, dtype=torch.bfloat16) * 0.8)(B, H, Sq, Dh)),
        "k": _w((lambda *s: torch.randn(*s, dtype=torch.bfloat16) * 0.8)(B, H, Skv, Dh)),
        "v": _w((lambda *s: torch.randn(*s, dtype=torch.bfloat16) * 0.05)(B, H, Skv, Dh)),
    }

def reference(q, k, v):
    scale = q.shape[-1] ** -0.5
    scores = torch.einsum('bhqd,bhkd->bhqk', q, k) * scale
    attn = _softmax(scores, axis=-1)
    return torch.einsum('bhqk,bhkd->bhqd', attn, v)
```

```asm
; @launch grid=(256,1,1) block=(320,1,1) lds=45312
.amdgcn_target "amdgcn-amd-amdhsa--gfx950"
.text
.globl standalone__softmax_full_bidir__decode_kernel
.p2align 8
.type standalone__softmax_full_bidir__decode_kernel,@function
standalone__softmax_full_bidir__decode_kernel:
    s_cmp_ge_u32 s2, 256
    s_cbranch_scc1 L_done
    s_load_dwordx4 s[32:35], s[0:1], 0
    s_load_dwordx4 s[36:39], s[0:1], 16
    s_load_dwordx4 s[40:43], s[0:1], 32
    v_and_b32 v3, 63, v0
    v_lshrrev_b32 v48, 6, v0
    v_lshrrev_b32 v49, 4, v3
    v_readfirstlane_b32 s25, v48
    s_lshr_b32 s23, s2, 3
    s_and_b32 s24, s2, 7
    v_bfe_u32 v50, v3, 2, 2
    v_lshlrev_b32 v50, 9, v50
    v_lshl_add_u32 v50, v49, 6, v50
    v_and_b32 v51, 3, v3
    v_lshl_add_u32 v1, v51, 4, v50
    v_and_b32 v52, 15, v3
    v_lshlrev_b32 v52, 4, v52
    v_lshl_add_u32 v2, v49, 9, v52
    v_lshlrev_b32 v51, 4, v51
    v_lshl_add_u32 v53, v49, 6, v51
    v_mov_b32 v57, 0
    v_mov_b32 v19, v1
    s_lshr_b32 s29, s23, 8
    s_lshl_b32 s28, s23, 24
    s_mul_i32 s27, s25, 4096
    s_mul_i32 s71, s24, 96
    s_add_u32 s64, s71, 0
    s_add_u32 s65, s71, 1
    s_lshl_b32 s70, s23, 8
    s_add_u32 s70, s70, 0x100000
    v_mul_u32_u24 v61, 8, v49
    s_mul_i32 s30, s25, 32
    v_add_u32 v61, s30, v61
    s_mul_i32 s88, s24, 32
    s_lshr_b32 s89, s24, 2
    s_add_u32 s20, s64, s88
    s_sub_u32 s21, s64, 768
    s_lshr_b32 s92, s21, 7
    s_lshl_b32 s92, s92, 2
    s_and_b32 s21, s21, 127
    s_bfe_u32 s93, s21, 0x20002
    s_add_u32 s92, s92, s93
    s_lshl_b32 s92, s92, 7
    s_lshr_b32 s93, s21, 4
    s_lshl_b32 s93, s93, 2
    s_add_u32 s92, s92, s93
    s_and_b32 s21, s21, 3
    s_add_u32 s21, s21, s92
    s_add_u32 s21, s21, 96
    s_cmp_ge_u32 s64, 768
    s_cselect_b32 s20, s21, s20
    s_mul_i32 s20, s20, 16384
    s_add_u32 s20, s20, s27
    s_cmp_eq_u32 s25, 4
    s_waitcnt lgkmcnt(0)
    s_cbranch_scc1 L_helper
    s_add_u32 s12, s34, s28
    s_addc_u32 s13, s35, s29
    s_and_b32 s13, s13, 0xffff
    s_mov_b32 s14, 16777216
    s_mov_b32 s15, 0x00020000
    s_add_u32 s4, s36, s28
    s_addc_u32 s5, s37, s29
    s_and_b32 s5, s5, 0xffff
    buffer_load_dwordx4 v[84:87], v19, s[12:15], s20 offen offset:0 nt
    buffer_load_dwordx4 v[88:91], v19, s[12:15], s20 offen offset:256 nt
    buffer_load_dwordx4 v[92:95], v19, s[12:15], s20 offen offset:2048 nt
    buffer_load_dwordx4 v[96:99], v19, s[12:15], s20 offen offset:2304 nt
    s_mov_b32 s16, s32
    s_and_b32 s17, s33, 0xffff
    s_mov_b32 s18, 32768
    s_mov_b32 s19, 0x00020000
    s_lshl_b32 s28, s23, 10
    s_lshl_b32 s29, s89, 9
    s_or_b32 s28, s28, s29
    s_xor_b32 s29, s28, 512
    buffer_load_dwordx4 v[4:7], v53, s[16:19], s28 offen offset:0
    buffer_load_dwordx4 v[8:11], v53, s[16:19], s28 offen offset:256
    buffer_load_dwordx4 v[64:67], v53, s[16:19], s29 offen offset:0
    buffer_load_dwordx4 v[68:71], v53, s[16:19], s29 offen offset:256
    s_add_u32 s20, s65, s88
    s_sub_u32 s21, s65, 768
    s_lshr_b32 s92, s21, 7
    s_lshl_b32 s92, s92, 2
    s_and_b32 s21, s21, 127
    s_bfe_u32 s93, s21, 0x20002
    s_add_u32 s92, s92, s93
    s_lshl_b32 s92, s92, 7
    s_lshr_b32 s93, s21, 4
    s_lshl_b32 s93, s93, 2
    s_add_u32 s92, s92, s93
    s_and_b32 s21, s21, 3
    s_add_u32 s21, s21, s92
    s_add_u32 s21, s21, 96
    s_cmp_ge_u32 s65, 768
    s_cselect_b32 s20, s21, s20
    s_mul_i32 s20, s20, 16384
    s_add_u32 s20, s20, s27
    buffer_load_dwordx4 v[100:103], v19, s[12:15], s20 offen offset:0 nt
    buffer_load_dwordx4 v[104:107], v19, s[12:15], s20 offen offset:256 nt
    buffer_load_dwordx4 v[108:111], v19, s[12:15], s20 offen offset:2048 nt
    buffer_load_dwordx4 v[112:115], v19, s[12:15], s20 offen offset:2304 nt
    s_mov_b32 s44, s38
    s_and_b32 s45, s39, 0xffff
    s_mov_b32 s46, 32768
    s_mov_b32 s47, 0x00020000
    v_and_b32 v48, 1, v3
    v_lshlrev_b32 v48, 4, v48
    v_mov_b32 v49, 0xffff
    v_lshlrev_b32 v48, v48, v49
    v_bfe_u32 v49, v3, 1, 2
    v_cmp_eq_u32 vcc, 0, v49
    s_nop 1
    v_cndmask_b32 v12, 0, v48, vcc
    v_cmp_eq_u32 vcc, 1, v49
    s_nop 1
    v_cndmask_b32 v13, 0, v48, vcc
    v_cmp_eq_u32 vcc, 2, v49
    s_nop 1
    v_cndmask_b32 v14, 0, v48, vcc
    v_cmp_eq_u32 vcc, 3, v49
    s_nop 1
    v_cndmask_b32 v15, 0, v48, vcc
    v_mov_b32 v16, 0xff7fffff
    v_mov_b32 v17, 0
    v_mov_b32 v20, 0
    v_mov_b32 v21, 0
    v_mov_b32 v22, 0
    v_mov_b32 v23, 0
    v_mov_b32 v24, 0
    v_mov_b32 v25, 0
    v_mov_b32 v26, 0
    v_mov_b32 v27, 0
    s_mov_b32 s26, 0x3db8aa3b
    s_mov_b32 s22, 768
    s_mov_b32 s68, 0
    s_mov_b32 s69, 0x7fffffff
    v_mov_b32 v55, 8456
    v_mov_b32 v58, 0
    v_mov_b32 v63, 0
    s_lshl_b32 s28, s25, 2
    s_add_u32 s28, s28, 8416
    v_mov_b32 v56, s28
    v_mov_b32 v62, 8432
    v_add_u32 v59, 12544, v61
    s_barrier
L_k_0:
    s_cmp_ge_u32 s68, s69
    s_cbranch_scc1 L_tov_0
L_k2_0:
    s_cmp_lt_u32 s64, s22
    s_cbranch_scc0 L_ksw_0
L_kgo_0:
    ds_write_b32 v56, v58
    ds_read_b32 v54, v55
    s_waitcnt vmcnt(4)
    v_mfma_f32_16x16x32_bf16 v[28:31], v[84:87], v[4:7], 0
    v_mfma_f32_16x16x32_bf16 v[32:35], v[92:95], v[4:7], 0
    v_mfma_f32_16x16x32_bf16 v[28:31], v[88:91], v[8:11], v[28:31]
    v_mfma_f32_16x16x32_bf16 v[32:35], v[96:99], v[8:11], v[32:35]
    s_waitcnt lgkmcnt(0)
    v_readfirstlane_b32 s64, v54
    s_cmp_ge_u32 s64, 1024
    s_cbranch_scc1 L_kx_0
L_khave_0:
    s_add_u32 s20, s64, s88
    s_sub_u32 s21, s64, 768
    s_lshr_b32 s92, s21, 7
    s_lshl_b32 s92, s92, 2
    s_and_b32 s21, s21, 127
    s_bfe_u32 s93, s21, 0x20002
    s_add_u32 s92, s92, s93
    s_lshl_b32 s92, s92, 7
    s_lshr_b32 s93, s21, 4
    s_lshl_b32 s93, s93, 2
    s_add_u32 s92, s92, s93
    s_and_b32 s21, s21, 3
    s_add_u32 s21, s21, s92
    s_add_u32 s21, s21, 96
    s_cmp_ge_u32 s64, 768
    s_cselect_b32 s20, s21, s20
    s_mul_i32 s20, s20, 16384
    s_add_u32 s20, s20, s27
    buffer_load_dwordx4 v[84:87], v19, s[12:15], s20 offen offset:0 nt
    buffer_load_dwordx4 v[88:91], v19, s[12:15], s20 offen offset:256 nt
    buffer_load_dwordx4 v[92:95], v19, s[12:15], s20 offen offset:2048 nt
    buffer_load_dwordx4 v[96:99], v19, s[12:15], s20 offen offset:2304 nt
    v_add_u32 v55, 4, v55
    s_nop 1
    v_mov_b32_dpp v44, v28 quad_perm:[0,0,0,0] row_mask:0xf bank_mask:0xf
    v_mov_b32_dpp v45, v32 quad_perm:[0,0,0,0] row_mask:0xf bank_mask:0xf
    s_nop 1
    v_add_f32_dpp v44, v29, v44 quad_perm:[1,1,1,1] row_mask:0xf bank_mask:0xf
    v_add_f32_dpp v45, v33, v45 quad_perm:[1,1,1,1] row_mask:0xf bank_mask:0xf
    s_nop 1
    v_add_f32_dpp v44, v30, v44 quad_perm:[2,2,2,2] row_mask:0xf bank_mask:0xf
    v_add_f32_dpp v45, v34, v45 quad_perm:[2,2,2,2] row_mask:0xf bank_mask:0xf
    s_nop 1
    v_add_f32_dpp v44, v31, v44 quad_perm:[3,3,3,3] row_mask:0xf bank_mask:0xf
    v_add_f32_dpp v45, v35, v45 quad_perm:[3,3,3,3] row_mask:0xf bank_mask:0xf
    ds_write_b64 v59, v[44:45]
    v_max3_f32 v16, v16, v44, v45
    v_add_u32 v59, 128, v59
    v_add_u32 v58, 1, v58
    s_add_u32 s68, s68, 1
L_k_1:
    s_cmp_ge_u32 s68, s69
    s_cbranch_scc1 L_tov_1
L_k2_1:
    s_cmp_lt_u32 s65, s22
    s_cbranch_scc0 L_ksw_1
L_kgo_1:
    ds_write_b32 v56, v58
    ds_read_b32 v54, v55
    s_waitcnt vmcnt(4)
    v_mfma_f32_16x16x32_bf16 v[28:31], v[100:103], v[4:7], 0
    v_mfma_f32_16x16x32_bf16 v[32:35], v[108:111], v[4:7], 0
    v_mfma_f32_16x16x32_bf16 v[28:31], v[104:107], v[8:11], v[28:31]
    v_mfma_f32_16x16x32_bf16 v[32:35], v[112:115], v[8:11], v[32:35]
    s_waitcnt lgkmcnt(0)
    v_readfirstlane_b32 s65, v54
    s_cmp_ge_u32 s65, 1024
    s_cbranch_scc1 L_kx_1
L_khave_1:
    s_add_u32 s20, s65, s88
    s_sub_u32 s21, s65, 768
    s_lshr_b32 s92, s21, 7
    s_lshl_b32 s92, s92, 2
    s_and_b32 s21, s21, 127
    s_bfe_u32 s93, s21, 0x20002
    s_add_u32 s92, s92, s93
    s_lshl_b32 s92, s92, 7
    s_lshr_b32 s93, s21, 4
    s_lshl_b32 s93, s93, 2
    s_add_u32 s92, s92, s93
    s_and_b32 s21, s21, 3
    s_add_u32 s21, s21, s92
    s_add_u32 s21, s21, 96
    s_cmp_ge_u32 s65, 768
    s_cselect_b32 s20, s21, s20
    s_mul_i32 s20, s20, 16384
    s_add_u32 s20, s20, s27
    buffer_load_dwordx4 v[100:103], v19, s[12:15], s20 offen offset:0 nt
    buffer_load_dwordx4 v[104:107], v19, s[12:15], s20 offen offset:256 nt
    buffer_load_dwordx4 v[108:111], v19, s[12:15], s20 offen offset:2048 nt
    buffer_load_dwordx4 v[112:115], v19, s[12:15], s20 offen offset:2304 nt
    v_add_u32 v55, 4, v55
    s_nop 1
    v_mov_b32_dpp v44, v28 quad_perm:[0,0,0,0] row_mask:0xf bank_mask:0xf
    v_mov_b32_dpp v45, v32 quad_perm:[0,0,0,0] row_mask:0xf bank_mask:0xf
    s_nop 1
    v_add_f32_dpp v44, v29, v44 quad_perm:[1,1,1,1] row_mask:0xf bank_mask:0xf
    v_add_f32_dpp v45, v33, v45 quad_perm:[1,1,1,1] row_mask:0xf bank_mask:0xf
    s_nop 1
    v_add_f32_dpp v44, v30, v44 quad_perm:[2,2,2,2] row_mask:0xf bank_mask:0xf
    v_add_f32_dpp v45, v34, v45 quad_perm:[2,2,2,2] row_mask:0xf bank_mask:0xf
    s_nop 1
    v_add_f32_dpp v44, v31, v44 quad_perm:[3,3,3,3] row_mask:0xf bank_mask:0xf
    v_add_f32_dpp v45, v35, v45 quad_perm:[3,3,3,3] row_mask:0xf bank_mask:0xf
    ds_write_b64 v59, v[44:45]
    v_max3_f32 v16, v16, v44, v45
    v_add_u32 v59, 128, v59
    v_add_u32 v58, 1, v58
    s_add_u32 s68, s68, 1
    s_branch L_k_0
L_kx_0:
    s_cmp_eq_u32 s64, -1
    s_cbranch_scc0 L_kinv_0
    s_sleep 1
    ds_read_b32 v54, v55
    s_waitcnt lgkmcnt(0)
    v_readfirstlane_b32 s64, v54
    s_cmp_ge_u32 s64, 1024
    s_cbranch_scc1 L_kx_0
    s_branch L_khave_0
L_kinv_0:
    s_add_u32 s69, s68, 2
    s_mov_b32 s12, s4
    s_mov_b32 s13, s5
    v_mov_b32 v19, v2
    s_mov_b32 s64, s71
    v_mov_b32 v55, 10496
    s_branch L_khave_0
L_ksw_0:
    s_cmp_eq_u32 s22, 768
    s_cbranch_scc0 L_kswap_0
    v_mov_b32 v82, v16
    s_mov_b32 s22, 896
    s_cmp_eq_u32 s89, 0
    s_cbranch_scc1 L_k2_0
    s_cmp_lt_u32 s64, 896
    s_cbranch_scc1 L_kswap2_0
    s_mov_b32 s22, 0x7fffffff
    s_branch L_kgo_0
L_kswap_0:
    s_mov_b32 s22, 0x7fffffff
L_kswap2_0:
    s_waitcnt vmcnt(4)
    v_swap_b32 v4, v64
    v_swap_b32 v5, v65
    v_swap_b32 v6, v66
    v_swap_b32 v7, v67
    v_swap_b32 v8, v68
    v_swap_b32 v9, v69
    v_swap_b32 v10, v70
    v_swap_b32 v11, v71
    s_branch L_kgo_0
L_tov_0:
    s_mov_b32 s31, 0
    s_branch L_tov
L_kx_1:
    s_cmp_eq_u32 s65, -1
    s_cbranch_scc0 L_kinv_1
    s_sleep 1
    ds_read_b32 v54, v55
    s_waitcnt lgkmcnt(0)
    v_readfirstlane_b32 s65, v54
    s_cmp_ge_u32 s65, 1024
    s_cbranch_scc1 L_kx_1
    s_branch L_khave_1
L_kinv_1:
    s_add_u32 s69, s68, 2
    s_mov_b32 s12, s4
    s_mov_b32 s13, s5
    v_mov_b32 v19, v2
    s_mov_b32 s65, s71
    v_mov_b32 v55, 10496
    s_branch L_khave_1
L_ksw_1:
    s_cmp_eq_u32 s22, 768
    s_cbranch_scc0 L_kswap_1
    v_mov_b32 v82, v16
    s_mov_b32 s22, 896
    s_cmp_eq_u32 s89, 0
    s_cbranch_scc1 L_k2_1
    s_cmp_lt_u32 s65, 896
    s_cbranch_scc1 L_kswap2_1
    s_mov_b32 s22, 0x7fffffff
    s_branch L_kgo_1
L_kswap_1:
    s_mov_b32 s22, 0x7fffffff
L_kswap2_1:
    s_waitcnt vmcnt(4)
    v_swap_b32 v4, v64
    v_swap_b32 v5, v65
    v_swap_b32 v6, v66
    v_swap_b32 v7, v67
    v_swap_b32 v8, v68
    v_swap_b32 v9, v69
    v_swap_b32 v10, v70
    v_swap_b32 v11, v71
    s_branch L_kgo_1
L_tov_1:
    s_mov_b32 s31, 1
    s_branch L_tov
L_tov:
    ds_write_b32 v56, v58
    s_cmp_eq_u32 s22, 768
    s_cbranch_scc0 L_tov_sw
    v_mov_b32 v82, v16
L_tov_sw:
    v_mov_b32 v49, v82
    s_nop 1
    v_permlane16_swap_b32 v82, v49
    s_nop 1
    v_max_f32 v82, v82, v49
    v_mov_b32 v49, v82
    s_nop 1
    v_permlane32_swap_b32 v82, v49
    s_nop 1
    v_max_f32 v82, v82, v49
    v_mul_f32 v18, s26, v82
    v_mov_b32 v72, 0
    v_mov_b32 v73, 0
    v_mov_b32 v74, 0
    v_mov_b32 v75, 0
    v_mov_b32 v76, 0
    v_mov_b32 v77, 0
    v_mov_b32 v78, 0
    v_mov_b32 v79, 0
    v_mov_b32 v81, 0
    v_mov_b32 v80, 0xff7fffff
    v_add_u32 v59, 12544, v61
    s_mov_b32 s22, 768
    s_cmp_eq_u32 s31, 0
    s_cbranch_scc1 L_v_0
    s_branch L_v_1
L_v_0:
    s_cmp_lt_u32 s64, s22
    s_cbranch_scc0 L_vsw_0
    ds_max_u32 v62, v63
    ds_read_b32 v54, v55
    ds_read_b64 v[44:45], v59
    v_add_u32 v59, 128, v59
    v_add_u32 v63, 1, v63
    s_waitcnt lgkmcnt(0)
    v_readfirstlane_b32 s64, v54
    s_cmp_eq_u32 s64, -1
    s_cbranch_scc1 L_vpoll_0
L_vhave_0:
    s_add_u32 s20, s64, s88
    s_sub_u32 s21, s64, 768
    s_lshr_b32 s92, s21, 7
    s_lshl_b32 s92, s92, 2
    s_and_b32 s21, s21, 127
    s_bfe_u32 s93, s21, 0x20002
    s_add_u32 s92, s92, s93
    s_lshl_b32 s92, s92, 7
    s_lshr_b32 s93, s21, 4
    s_lshl_b32 s93, s93, 2
    s_add_u32 s92, s92, s93
    s_and_b32 s21, s21, 3
    s_add_u32 s21, s21, s92
    s_add_u32 s21, s21, 96
    s_cmp_ge_u32 s64, 768
    s_cselect_b32 s20, s21, s20
    s_mul_i32 s20, s20, 16384
    s_add_u32 s20, s20, s27
    v_add_u32 v55, 4, v55
    v_fma_f32 v44, v44, s26, -v18
    v_fma_f32 v45, v45, s26, -v18
    v_exp_f32 v44, v44
    v_exp_f32 v45, v45
    s_nop 0
    v_add_f32 v17, v17, v44
    v_add_f32 v17, v17, v45
    v_cvt_pk_bf16_f32 v44, v44, v44
    v_cvt_pk_bf16_f32 v45, v45, v45
    v_and_b32 v28, v44, v12
    v_and_b32 v29, v44, v13
    v_and_b32 v30, v44, v14
    v_and_b32 v31, v44, v15
    v_and_b32 v32, v45, v12
    v_and_b32 v33, v45, v13
    v_and_b32 v34, v45, v14
    v_and_b32 v35, v45, v15
    s_waitcnt vmcnt(4)
    s_nop 1
    v_mfma_f32_16x16x32_bf16 v[20:23], v[28:31], v[84:87], v[20:23]
    v_mfma_f32_16x16x32_bf16 v[24:27], v[28:31], v[88:91], v[24:27]
    v_mfma_f32_16x16x32_bf16 v[20:23], v[32:35], v[92:95], v[20:23]
    v_mfma_f32_16x16x32_bf16 v[24:27], v[32:35], v[96:99], v[24:27]
    buffer_load_dwordx4 v[84:87], v19, s[12:15], s20 offen offset:0 nt
    buffer_load_dwordx4 v[88:91], v19, s[12:15], s20 offen offset:256 nt
    buffer_load_dwordx4 v[92:95], v19, s[12:15], s20 offen offset:2048 nt
    buffer_load_dwordx4 v[96:99], v19, s[12:15], s20 offen offset:2304 nt
L_v_1:
    s_cmp_lt_u32 s65, s22
    s_cbranch_scc0 L_vsw_1
    ds_max_u32 v62, v63
    ds_read_b32 v54, v55
    ds_read_b64 v[44:45], v59
    v_add_u32 v59, 128, v59
    v_add_u32 v63, 1, v63
    s_waitcnt lgkmcnt(0)
    v_readfirstlane_b32 s65, v54
    s_cmp_eq_u32 s65, -1
    s_cbranch_scc1 L_vpoll_1
L_vhave_1:
    s_add_u32 s20, s65, s88
    s_sub_u32 s21, s65, 768
    s_lshr_b32 s92, s21, 7
    s_lshl_b32 s92, s92, 2
    s_and_b32 s21, s21, 127
    s_bfe_u32 s93, s21, 0x20002
    s_add_u32 s92, s92, s93
    s_lshl_b32 s92, s92, 7
    s_lshr_b32 s93, s21, 4
    s_lshl_b32 s93, s93, 2
    s_add_u32 s92, s92, s93
    s_and_b32 s21, s21, 3
    s_add_u32 s21, s21, s92
    s_add_u32 s21, s21, 96
    s_cmp_ge_u32 s65, 768
    s_cselect_b32 s20, s21, s20
    s_mul_i32 s20, s20, 16384
    s_add_u32 s20, s20, s27
    v_add_u32 v55, 4, v55
    v_fma_f32 v44, v44, s26, -v18
    v_fma_f32 v45, v45, s26, -v18
    v_exp_f32 v44, v44
    v_exp_f32 v45, v45
    s_nop 0
    v_add_f32 v17, v17, v44
    v_add_f32 v17, v17, v45
    v_cvt_pk_bf16_f32 v44, v44, v44
    v_cvt_pk_bf16_f32 v45, v45, v45
    v_and_b32 v28, v44, v12
    v_and_b32 v29, v44, v13
    v_and_b32 v30, v44, v14
    v_and_b32 v31, v44, v15
    v_and_b32 v32, v45, v12
    v_and_b32 v33, v45, v13
    v_and_b32 v34, v45, v14
    v_and_b32 v35, v45, v15
    s_waitcnt vmcnt(4)
    s_nop 1
    v_mfma_f32_16x16x32_bf16 v[20:23], v[28:31], v[100:103], v[20:23]
    v_mfma_f32_16x16x32_bf16 v[24:27], v[28:31], v[104:107], v[24:27]
    v_mfma_f32_16x16x32_bf16 v[20:23], v[32:35], v[108:111], v[20:23]
    v_mfma_f32_16x16x32_bf16 v[24:27], v[32:35], v[112:115], v[24:27]
    buffer_load_dwordx4 v[100:103], v19, s[12:15], s20 offen offset:0 nt
    buffer_load_dwordx4 v[104:107], v19, s[12:15], s20 offen offset:256 nt
    buffer_load_dwordx4 v[108:111], v19, s[12:15], s20 offen offset:2048 nt
    buffer_load_dwordx4 v[112:115], v19, s[12:15], s20 offen offset:2304 nt
    s_branch L_v_0
L_vpoll_0:
    s_sleep 1
    ds_read_b32 v54, v55
    s_waitcnt lgkmcnt(0)
    v_readfirstlane_b32 s64, v54
    s_cmp_eq_u32 s64, -1
    s_cbranch_scc1 L_vpoll_0
    s_branch L_vhave_0
L_vsw_0:
    s_cmp_eq_u32 s22, 1024
    s_cbranch_scc1 L_epi
    s_nop 7
    s_cmp_eq_u32 s22, 768
    s_cbranch_scc0 L_vswap_0
    s_lshl_b32 s28, s89, 2
    s_add_u32 s28, s28, 8436
    s_xor_b32 s29, s28, 12
    v_mov_b32 v48, s28
    v_mov_b32 v50, s29
    ds_read_b32 v49, v48
    ds_read_b32 v80, v50
    s_waitcnt lgkmcnt(0)
    v_max_f32 v49, v49, v18
    v_sub_f32 v48, v18, v49
    v_mov_b32 v18, v49
    v_exp_f32 v48, v48
    s_nop 0
    v_mul_f32 v17, v17, v48
    v_mul_f32 v20, v20, v48
    v_mul_f32 v21, v21, v48
    v_mul_f32 v22, v22, v48
    v_mul_f32 v23, v23, v48
    v_mul_f32 v24, v24, v48
    v_mul_f32 v25, v25, v48
    v_mul_f32 v26, v26, v48
    v_mul_f32 v27, v27, v48
    s_mov_b32 s22, 896
    s_cmp_eq_u32 s89, 0
    s_cbranch_scc1 L_v_0
    s_cmp_lt_u32 s64, 896
    s_cbranch_scc1 L_vswap2_0
    s_mov_b32 s22, 1024
    s_branch L_v_0
L_vswap_0:
    s_mov_b32 s22, 1024
L_vswap2_0:
    v_swap_b32 v20, v72
    v_swap_b32 v21, v73
    v_swap_b32 v22, v74
    v_swap_b32 v23, v75
    v_swap_b32 v24, v76
    v_swap_b32 v25, v77
    v_swap_b32 v26, v78
    v_swap_b32 v27, v79
    v_swap_b32 v17, v81
    v_swap_b32 v18, v80
    s_branch L_v_0
L_vpoll_1:
    s_sleep 1
    ds_read_b32 v54, v55
    s_waitcnt lgkmcnt(0)
    v_readfirstlane_b32 s65, v54
    s_cmp_eq_u32 s65, -1
    s_cbranch_scc1 L_vpoll_1
    s_branch L_vhave_1
L_vsw_1:
    s_cmp_eq_u32 s22, 1024
    s_cbranch_scc1 L_epi
    s_nop 7
    s_cmp_eq_u32 s22, 768
    s_cbranch_scc0 L_vswap_1
    s_lshl_b32 s28, s89, 2
    s_add_u32 s28, s28, 8436
    s_xor_b32 s29, s28, 12
    v_mov_b32 v48, s28
    v_mov_b32 v50, s29
    ds_read_b32 v49, v48
    ds_read_b32 v80, v50
    s_waitcnt lgkmcnt(0)
    v_max_f32 v49, v49, v18
    v_sub_f32 v48, v18, v49
    v_mov_b32 v18, v49
    v_exp_f32 v48, v48
    s_nop 0
    v_mul_f32 v17, v17, v48
    v_mul_f32 v20, v20, v48
    v_mul_f32 v21, v21, v48
    v_mul_f32 v22, v22, v48
    v_mul_f32 v23, v23, v48
    v_mul_f32 v24, v24, v48
    v_mul_f32 v25, v25, v48
    v_mul_f32 v26, v26, v48
    v_mul_f32 v27, v27, v48
    s_mov_b32 s22, 896
    s_cmp_eq_u32 s89, 0
    s_cbranch_scc1 L_v_1
    s_cmp_lt_u32 s65, 896
    s_cbranch_scc1 L_vswap2_1
    s_mov_b32 s22, 1024
    s_branch L_v_1
L_vswap_1:
    s_mov_b32 s22, 1024
L_vswap2_1:
    v_swap_b32 v20, v72
    v_swap_b32 v21, v73
    v_swap_b32 v22, v74
    v_swap_b32 v23, v75
    v_swap_b32 v24, v76
    v_swap_b32 v25, v77
    v_swap_b32 v26, v78
    v_swap_b32 v27, v79
    v_swap_b32 v17, v81
    v_swap_b32 v18, v80
    s_branch L_v_1
L_epi:
    s_mov_b32 s16, s42
    s_and_b32 s17, s43, 0xffff
    s_mov_b32 s18, 3145728
    s_mov_b32 s19, 0x00020000
    s_nop 7
    v_mov_b32 v49, v81
    s_nop 1
    v_permlane16_swap_b32 v81, v49
    s_nop 1
    v_add_f32 v81, v81, v49
    v_mov_b32 v49, v81
    s_nop 1
    v_permlane32_swap_b32 v81, v49
    s_nop 1
    v_add_f32 v81, v81, v49
    v_mov_b32 v49, v17
    s_nop 1
    v_permlane16_swap_b32 v17, v49
    s_nop 1
    v_add_f32 v17, v17, v49
    v_mov_b32 v49, v17
    s_nop 1
    v_permlane32_swap_b32 v17, v49
    s_nop 1
    v_add_f32 v17, v17, v49
    v_and_b32 v48, 15, v3
    v_lshlrev_b32 v48, 5, v48
    v_bfe_u32 v49, v3, 4, 1
    v_lshl_add_u32 v48, v49, 4, v48
    s_lshl_b32 s28, s25, 10
    v_add_u32 v48, s28, v48
    ds_write_b128 v48, v[72:75]
    ds_write_b128 v48, v[76:79] offset:512
    ds_write_b128 v48, v[20:23] offset:4096
    ds_write_b128 v48, v[24:27] offset:4608
    s_lshl_b32 s28, s25, 2
    v_mov_b32 v50, s28
    ds_write_b32 v50, v80 offset:8192
    ds_write_b32 v50, v81 offset:8256
    ds_write_b32 v50, v18 offset:8320
    ds_write_b32 v50, v17 offset:8384
    s_waitcnt vmcnt(0) lgkmcnt(0)
    s_barrier
    s_cmp_ge_u32 s25, 2
    s_cbranch_scc1 L_fin
    s_lshl_b32 s28, s25, 7
    v_mov_b32 v48, s28
    ds_read_b128 v[84:87], v48 offset:8192
    ds_read_b128 v[100:103], v48 offset:8256
    v_lshlrev_b32 v49, 4, v3
    s_lshl_b32 s28, s25, 12
    v_add_u32 v50, s28, v49
    ds_read_b128 v[116:119], v50 offset:0
    ds_read_b128 v[120:123], v50 offset:1024
    ds_read_b128 v[124:127], v50 offset:2048
    ds_read_b128 v[128:131], v50 offset:3072
    s_lshl_b32 s28, s2, 1
    s_add_u32 s28, s28, s25
    s_mul_i32 s28, s28, 1152
    s_lshl_b32 s30, s23, 1
    s_add_u32 s30, s30, s25
    s_lshl_b32 s31, s25, 2
    s_add_u32 s31, s31, s70
    s_add_u32 s78, s42, s31
    s_addc_u32 s79, s43, 0
    s_waitcnt lgkmcnt(4)
    v_max_f32 v18, v84, v85
    v_max3_f32 v18, v18, v86, v87
    v_sub_f32 v84, v84, v18
    v_sub_f32 v85, v85, v18
    v_sub_f32 v86, v86, v18
    v_sub_f32 v87, v87, v18
    v_exp_f32 v84, v84
    v_exp_f32 v85, v85
    v_exp_f32 v86, v86
    v_exp_f32 v87, v87
    s_nop 0
    v_mul_f32 v17, v84, v100
    v_fmac_f32 v17, v85, v101
    v_fmac_f32 v17, v86, v102
    v_fmac_f32 v17, v87, v103
    s_waitcnt lgkmcnt(3)
    v_mul_f32 v20, v84, v116
    v_mul_f32 v21, v84, v117
    v_mul_f32 v22, v84, v118
    v_mul_f32 v23, v84, v119
    s_waitcnt lgkmcnt(2)
    v_fmac_f32 v20, v85, v120
    v_fmac_f32 v21, v85, v121
    v_fmac_f32 v22, v85, v122
    v_fmac_f32 v23, v85, v123
    s_waitcnt lgkmcnt(1)
    v_fmac_f32 v20, v86, v124
    v_fmac_f32 v21, v86, v125
    v_fmac_f32 v22, v86, v126
    v_fmac_f32 v23, v86, v127
    s_waitcnt lgkmcnt(0)
    v_fmac_f32 v20, v87, v128
    v_fmac_f32 v21, v87, v129
    v_fmac_f32 v22, v87, v130
    v_fmac_f32 v23, v87, v131
    v_mov_b32 v50, v18
    v_mov_b32 v51, v17
    buffer_store_dwordx4 v[20:23], v49, s[16:19], s28 offen sc0 sc1
    s_mov_b64 exec, 1
    buffer_store_dwordx2 v[50:51], v57, s[16:19], s28 offen offset:1024 sc0 sc1
    s_mov_b32 s29, 1
    s_waitcnt vmcnt(0)
    s_atomic_add s29, s[78:79], 0x4 glc
    s_mov_b64 exec, -1
    s_lshl_b32 s28, s23, 4
    s_add_u32 s28, s28, s25
    s_mul_i32 s28, s28, 1152
    s_waitcnt lgkmcnt(0)
    s_cmp_lg_u32 s29, 7
    s_cbranch_scc1 L_fin
    s_add_u32 s29, s28, 0
    buffer_load_dwordx2 v[84:85], v57, s[16:19], s29 offen offset:1024 sc0 sc1
    s_add_u32 s29, s28, 2304
    buffer_load_dwordx2 v[86:87], v57, s[16:19], s29 offen offset:1024 sc0 sc1
    s_add_u32 s29, s28, 4608
    buffer_load_dwordx2 v[88:89], v57, s[16:19], s29 offen offset:1024 sc0 sc1
    s_add_u32 s29, s28, 6912
    buffer_load_dwordx2 v[90:91], v57, s[16:19], s29 offen offset:1024 sc0 sc1
    s_add_u32 s29, s28, 9216
    buffer_load_dwordx2 v[92:93], v57, s[16:19], s29 offen offset:1024 sc0 sc1
    s_add_u32 s29, s28, 11520
    buffer_load_dwordx2 v[94:95], v57, s[16:19], s29 offen offset:1024 sc0 sc1
    s_add_u32 s29, s28, 13824
    buffer_load_dwordx2 v[96:97], v57, s[16:19], s29 offen offset:1024 sc0 sc1
    s_add_u32 s29, s28, 16128
    buffer_load_dwordx2 v[98:99], v57, s[16:19], s29 offen offset:1024 sc0 sc1
    s_add_u32 s29, s28, 0
    buffer_load_dwordx4 v[116:119], v49, s[16:19], s29 offen sc0 sc1
    s_add_u32 s29, s28, 2304
    buffer_load_dwordx4 v[120:123], v49, s[16:19], s29 offen sc0 sc1
    s_add_u32 s29, s28, 4608
    buffer_load_dwordx4 v[124:127], v49, s[16:19], s29 offen sc0 sc1
    s_add_u32 s29, s28, 6912
    buffer_load_dwordx4 v[128:131], v49, s[16:19], s29 offen sc0 sc1
    s_add_u32 s29, s28, 9216
    buffer_load_dwordx4 v[132:135], v49, s[16:19], s29 offen sc0 sc1
    s_add_u32 s29, s28, 11520
    buffer_load_dwordx4 v[136:139], v49, s[16:19], s29 offen sc0 sc1
    s_add_u32 s29, s28, 13824
    buffer_load_dwordx4 v[140:143], v49, s[16:19], s29 offen sc0 sc1
    s_add_u32 s29, s28, 16128
    buffer_load_dwordx4 v[144:147], v49, s[16:19], s29 offen sc0 sc1
    s_waitcnt vmcnt(8)
    v_max3_f32 v18, v84, v86, v88
    v_max3_f32 v18, v18, v90, v92
    v_max3_f32 v18, v18, v94, v96
    v_max_f32 v18, v18, v98
    v_sub_f32 v84, v84, v18
    v_sub_f32 v86, v86, v18
    v_sub_f32 v88, v88, v18
    v_sub_f32 v90, v90, v18
    v_sub_f32 v92, v92, v18
    v_sub_f32 v94, v94, v18
    v_sub_f32 v96, v96, v18
    v_sub_f32 v98, v98, v18
    v_exp_f32 v84, v84
    v_exp_f32 v86, v86
    v_exp_f32 v88, v88
    v_exp_f32 v90, v90
    v_exp_f32 v92, v92
    v_exp_f32 v94, v94
    v_exp_f32 v96, v96
    v_exp_f32 v98, v98
    s_nop 0
    v_mul_f32 v17, v84, v85
    v_fmac_f32 v17, v86, v87
    v_fmac_f32 v17, v88, v89
    v_fmac_f32 v17, v90, v91
    v_fmac_f32 v17, v92, v93
    v_fmac_f32 v17, v94, v95
    v_fmac_f32 v17, v96, v97
    v_fmac_f32 v17, v98, v99
    v_rcp_f32 v17, v17
    s_waitcnt vmcnt(7)
    v_mul_f32 v20, v84, v116
    v_mul_f32 v21, v84, v117
    v_mul_f32 v22, v84, v118
    v_mul_f32 v23, v84, v119
    s_waitcnt vmcnt(6)
    v_fmac_f32 v20, v86, v120
    v_fmac_f32 v21, v86, v121
    v_fmac_f32 v22, v86, v122
    v_fmac_f32 v23, v86, v123
    s_waitcnt vmcnt(5)
    v_fmac_f32 v20, v88, v124
    v_fmac_f32 v21, v88, v125
    v_fmac_f32 v22, v88, v126
    v_fmac_f32 v23, v88, v127
    s_waitcnt vmcnt(4)
    v_fmac_f32 v20, v90, v128
    v_fmac_f32 v21, v90, v129
    v_fmac_f32 v22, v90, v130
    v_fmac_f32 v23, v90, v131
    s_waitcnt vmcnt(3)
    v_fmac_f32 v20, v92, v132
    v_fmac_f32 v21, v92, v133
    v_fmac_f32 v22, v92, v134
    v_fmac_f32 v23, v92, v135
    s_waitcnt vmcnt(2)
    v_fmac_f32 v20, v94, v136
    v_fmac_f32 v21, v94, v137
    v_fmac_f32 v22, v94, v138
    v_fmac_f32 v23, v94, v139
    s_waitcnt vmcnt(1)
    v_fmac_f32 v20, v96, v140
    v_fmac_f32 v21, v96, v141
    v_fmac_f32 v22, v96, v142
    v_fmac_f32 v23, v96, v143
    s_waitcnt vmcnt(0)
    v_fmac_f32 v20, v98, v144
    v_fmac_f32 v21, v98, v145
    v_fmac_f32 v22, v98, v146
    v_fmac_f32 v23, v98, v147
    v_mul_f32 v20, v20, v17
    v_mul_f32 v21, v21, v17
    v_mul_f32 v22, v22, v17
    v_mul_f32 v23, v23, v17
    v_cvt_pk_bf16_f32 v20, v20, v21
    v_cvt_pk_bf16_f32 v21, v22, v23
    v_lshlrev_b32 v49, 3, v3
    s_lshl_b32 s28, s30, 9
    buffer_store_dwordx2 v[20:21], v49, s[44:47], s28 offen
L_fin:
L_done:
    s_endpgm
L_helper:
    s_setprio 3
    v_mov_b32 v48, -1
    v_mov_b32 v49, -1
    v_mov_b32 v50, -1
    v_mov_b32 v51, -1
    v_lshlrev_b32 v52, 4, v3
    ds_write_b128 v52, v[48:51] offset:8448
    ds_write_b128 v52, v[48:51] offset:9472
    ds_write_b128 v52, v[48:51] offset:10496
    ds_write_b128 v52, v[48:51] offset:11520
    v_add_u32 v48, s71, v3
    v_lshlrev_b32 v49, 2, v3
    ds_write_b32 v49, v48 offset:8448
    ds_write_b32 v49, v48 offset:10496
    v_add_u32 v48, 64, v48
    s_bfm_b64 exec, 32, 0
    ds_write_b32 v49, v48 offset:8704
    ds_write_b32 v49, v48 offset:10752
    s_mov_b64 exec, -1
    v_mov_b32 v20, 0
    v_mov_b32 v21, 0
    v_mov_b32 v22, 0
    v_mov_b32 v23, 0
    ds_write_b128 v57, v[20:23] offset:8416
    ds_write_b32 v57, v57 offset:8432
    s_waitcnt lgkmcnt(0)
    s_barrier
    s_mov_b32 s16, s42
    s_and_b32 s17, s43, 0xffff
    s_mov_b32 s18, 3145728
    s_mov_b32 s19, 0x00020000
    s_mov_b32 s48, s40
    s_and_b32 s49, s41, 0xffff
    s_mov_b32 s50, 256
    s_mov_b32 s51, 0x00020000
    s_mul_i32 s30, s23, 32768
    s_add_u32 s30, s30, 0x200000
    s_add_u32 s8, s42, s30
    s_addc_u32 s9, s43, 0
    s_and_b32 s9, s9, 0xffff
    s_mov_b32 s10, 32768
    s_mov_b32 s11, 0x00020000
    s_add_u32 s78, s42, s70
    s_addc_u32 s79, s43, 0
    s_mov_b32 s26, 0x3db8aa3b
    s_mov_b32 s72, 96
    s_mov_b32 s75, 0
    s_mov_b32 s85, 96
    s_mov_b32 s86, 96
    s_mov_b32 s87, 0
    v_mov_b32 v30, 0xff7fffff
    v_mov_b32 v31, 0xff7fffff
    v_mov_b32 v32, 0xff7fffff
    v_lshrrev_b32 v28, 3, v3
    v_and_b32 v29, 7, v3
    v_lshlrev_b32 v29, 4, v29
    s_mov_b64 exec, 1
    s_lshl_b32 s30, s23, 2
    s_add_u32 s30, s30, 128
    s_cmp_lg_u32 s24, 0
    s_cbranch_scc1 L_h_w0
    buffer_store_dwordx4 v[20:23], v57, s[16:19], s70 offen sc0 sc1
    buffer_store_dwordx4 v[20:23], v57, s[16:19], s70 offen offset:16 sc0 sc1
    s_waitcnt vmcnt(0)
    v_mov_b32 v48, 1
    buffer_store_dword v48, v57, s[48:51], s30 offen sc0 sc1
    s_waitcnt vmcnt(0)
L_h_w0:
    ds_read_b128 v[48:51], v57 offset:8416
    s_waitcnt lgkmcnt(0)
    v_min_u32 v52, v48, v49
    v_min3_u32 v52, v52, v50, v51
    v_max_u32 v53, v48, v49
    v_max3_u32 v53, v53, v50, v51
    s_nop 0
    v_readfirstlane_b32 s28, v52
    v_readfirstlane_b32 s73, v53
    s_add_u32 s73, s73, 7
    s_cmp_le_u32 s72, s73
    s_cbranch_scc1 L_h_pre
    s_sleep 16
    s_branch L_h_w0
L_h_pre:
L_h_flag:
    buffer_load_dword v48, v57, s[48:51], s30 offen sc0 sc1
    s_waitcnt vmcnt(0)
    v_readfirstlane_b32 s73, v48
    s_cmp_lg_u32 s73, 0
    s_cbranch_scc1 L_h_loop
    s_sleep 4
    s_branch L_h_flag
L_h_loop:
    ds_read_b128 v[48:51], v57 offset:8416
    s_waitcnt lgkmcnt(0)
    v_min_u32 v52, v48, v49
    v_min3_u32 v52, v52, v50, v51
    v_max_u32 v53, v48, v49
    v_max3_u32 v53, v53, v50, v51
    s_nop 0
    v_readfirstlane_b32 s28, v52
    v_readfirstlane_b32 s73, v53
    s_mov_b32 s90, s28
    s_cmp_eq_u32 s87, 0
    s_cbranch_scc1 L_h_noexp
    s_min_u32 s28, s28, s86
    s_sub_i32 s28, s28, s85
    s_min_i32 s28, s28, 7
    s_cmp_le_i32 s28, 0
    s_cbranch_scc1 L_h_noexp
    s_lshl_b32 s29, s28, 3
    s_bfm_b64 exec, s29, 0
    v_add_u32 v48, s85, v28
    v_lshlrev_b32 v49, 2, v48
    ds_read_b32 v50, v49 offset:8448
    v_lshl_add_u32 v51, v48, 7, v29
    ds_read_b128 v[24:27], v51 offset:12544
    s_add_u32 s85, s85, s28
    s_waitcnt lgkmcnt(0)
    v_subrev_u32 v50, 768, v50
    v_cmp_gt_u32 vcc, 128, v50
    v_lshl_add_u32 v50, v50, 7, v29
    buffer_store_dwordx4 v[24:27], v50, s[8:11], 0 offen sc0 sc1
    v_max3_f32 v52, v24, v25, v26
    v_max_f32 v52, v52, v27
    v_cndmask_b32 v53, v32, v52, vcc
    v_cndmask_b32 v52, v52, v32, vcc
    v_max_f32 v30, v30, v53
    v_max_f32 v31, v31, v52
    s_mov_b64 exec, 1
    s_branch L_h_loop
L_h_noexp:
    s_cmp_lg_u32 s87, 0
    s_cbranch_scc1 L_h_chk
    s_add_u32 s73, s73, 5
    s_cmp_le_u32 s72, s73
    s_cbranch_scc1 L_h_go
    s_sleep 1
    s_branch L_h_loop
L_h_go:
    s_sub_i32 s74, 256, s75
    s_ashr_i32 s74, s74, 4
    s_max_i32 s74, s74, 2
    s_min_i32 s74, s74, 16
    s_sub_i32 s29, 256, s72
    s_min_i32 s74, s74, s29
    s_cmp_le_i32 s74, 0
    s_cbranch_scc1 L_h_stop
    s_mov_b32 s75, s74
    s_atomic_add s75, s[78:79], 0x0 glc
    s_lshl_b32 s30, s72, 2
    s_add_u32 s30, s30, 8448
    s_lshl_b32 s29, 1, s74
    s_sub_u32 s29, s29, 1
    s_waitcnt lgkmcnt(0)
    s_mov_b64 exec, 0
    s_mov_b32 exec_lo, s29
    s_add_u32 s29, s75, 768
    v_add_u32 v49, s29, v3
    v_lshlrev_b32 v50, 2, v3
    v_add_u32 v50, s30, v50
    ds_write_b32 v50, v49
    s_mov_b64 exec, 1
    s_sub_i32 s29, 256, s75
    s_max_i32 s29, s29, 0
    s_min_i32 s29, s29, s74
    s_add_u32 s86, s86, s29
    s_add_u32 s72, s72, s74
    s_add_u32 s75, s75, s74
    s_cmp_lt_u32 s75, 256
    s_cbranch_scc1 L_h_loop
L_h_stop:
    s_mov_b64 exec, 0xff
    s_lshl_b32 s30, s72, 2
    s_add_u32 s30, s30, 8448
    v_lshlrev_b32 v48, 2, v3
    v_add_u32 v48, s30, v48
    v_mov_b32 v49, 1024
    ds_write_b32 v48, v49
    s_mov_b64 exec, 1
    s_mov_b32 s87, 1
    s_branch L_h_loop
L_h_chk:
    s_cmp_ge_u32 s85, s86
    s_cbranch_scc1 L_h_kend
    s_sleep 1
    s_branch L_h_loop
L_h_kend:
    s_mov_b64 exec, -1
    s_nop 1
    v_max_f32_dpp v30, v30, v30 quad_perm:[1,0,3,2] row_mask:0xf bank_mask:0xf
    s_nop 1
    v_max_f32_dpp v30, v30, v30 quad_perm:[2,3,0,1] row_mask:0xf bank_mask:0xf
    s_nop 1
    v_max_f32_dpp v30, v30, v30 row_half_mirror row_mask:0xf bank_mask:0xf
    s_nop 1
    v_max_f32_dpp v30, v30, v30 row_mirror row_mask:0xf bank_mask:0xf
    s_nop 1
    v_mov_b32 v49, v30
    s_nop 1
    v_permlane16_swap_b32 v30, v49
    s_nop 1
    v_max_f32 v30, v30, v49
    v_mov_b32 v49, v30
    s_nop 1
    v_permlane32_swap_b32 v30, v49
    s_nop 1
    v_max_f32 v30, v30, v49
    s_nop 1
    v_max_f32_dpp v31, v31, v31 quad_perm:[1,0,3,2] row_mask:0xf bank_mask:0xf
    s_nop 1
    v_max_f32_dpp v31, v31, v31 quad_perm:[2,3,0,1] row_mask:0xf bank_mask:0xf
    s_nop 1
    v_max_f32_dpp v31, v31, v31 row_half_mirror row_mask:0xf bank_mask:0xf
    s_nop 1
    v_max_f32_dpp v31, v31, v31 row_mirror row_mask:0xf bank_mask:0xf
    s_nop 1
    v_mov_b32 v49, v31
    s_nop 1
    v_permlane16_swap_b32 v31, v49
    s_nop 1
    v_max_f32 v31, v31, v49
    v_mov_b32 v49, v31
    s_nop 1
    v_permlane32_swap_b32 v31, v49
    s_nop 1
    v_max_f32 v31, v31, v49
    s_mov_b64 exec, 1
    s_lshl_b32 s30, s24, 2
    s_add_u32 s30, s30, s70
    buffer_store_dword v30, v57, s[16:19], s30 offen offset:128 sc0 sc1
    buffer_store_dword v31, v57, s[16:19], s30 offen offset:160 sc0 sc1
    s_waitcnt vmcnt(0)
    s_mov_b32 s29, 1
    s_atomic_add s29, s[78:79], 0x10 glc
    s_mov_b32 s72, 96
    s_mov_b32 s75, 0
    s_waitcnt lgkmcnt(0)
L_h_v0:
    ds_read_b32 v48, v57 offset:8432
    s_waitcnt lgkmcnt(0)
    v_readfirstlane_b32 s73, v48
    s_add_u32 s73, s73, 8
    s_cmp_le_u32 s72, s73
    s_cbranch_scc1 L_h_vpre
    s_sleep 16
    s_branch L_h_v0
L_h_vpre:
L_h_kd:
    s_mov_b32 s29, 0
    s_atomic_add s29, s[78:79], 0x10 glc
    s_waitcnt lgkmcnt(0)
    s_cmp_ge_u32 s29, 8
    s_cbranch_scc1 L_h_mx
    s_sleep 4
    s_branch L_h_kd
L_h_mx:
    s_mov_b64 exec, 0xffff
    v_lshlrev_b32 v48, 2, v3
    buffer_load_dword v30, v48, s[16:19], s70 offen offset:128 sc0 sc1
    s_waitcnt vmcnt(0)
    s_nop 1
    v_max_f32_dpp v30, v30, v30 quad_perm:[1,0,3,2] row_mask:0xf bank_mask:0xf
    s_nop 1
    v_max_f32_dpp v30, v30, v30 quad_perm:[2,3,0,1] row_mask:0xf bank_mask:0xf
    s_nop 1
    v_max_f32_dpp v30, v30, v30 row_half_mirror row_mask:0xf bank_mask:0xf
    s_mov_b64 exec, 0x101
    v_mul_f32 v30, s26, v30
    v_lshrrev_b32 v48, 1, v3
    ds_write_b32 v48, v30 offset:8436
    s_mov_b64 exec, 1
L_h_vloop:
    ds_read_b32 v48, v57 offset:8432
    s_waitcnt lgkmcnt(0)
    v_readfirstlane_b32 s73, v48
    s_add_u32 s73, s73, 4
    s_cmp_le_u32 s72, s73
    s_cbranch_scc1 L_h_vgo
    s_sleep 1
    s_branch L_h_vloop
L_h_vgo:
    s_sub_i32 s74, 256, s75
    s_ashr_i32 s74, s74, 5
    s_max_i32 s74, s74, 2
    s_min_i32 s74, s74, 7
    s_sub_i32 s29, 256, s72
    s_min_i32 s74, s74, s29
    s_cmp_le_i32 s74, 0
    s_cbranch_scc1 L_h_vstop
    s_mov_b32 s75, s74
    s_atomic_add s75, s[78:79], 0xc glc
    s_mov_b32 s95, s74
    s_waitcnt lgkmcnt(0)
L_h_vhave:
    s_mov_b32 s94, s75
    s_lshl_b32 s28, s95, 3
    s_bfm_b64 exec, s28, 0
    v_add_u32 v48, s94, v28
    v_lshl_add_u32 v48, v48, 7, v29
    buffer_load_dwordx4 v[24:27], v48, s[8:11], 0 offen sc0 sc1
    v_add_u32 v51, s72, v28
    v_lshl_add_u32 v51, v51, 7, v29
    s_mov_b64 exec, 1
    ds_read_b32 v48, v57 offset:8432
    s_lshl_b32 s30, s72, 2
    s_add_u32 s30, s30, 10496
    s_add_u32 s72, s72, s95
    s_add_u32 s75, s94, s95
    s_mov_b32 s91, 0
    s_mov_b32 s31, s95
    s_waitcnt lgkmcnt(0)
    v_readfirstlane_b32 s73, v48
    s_cmp_ge_u32 s75, 256
    s_cbranch_scc1 L_h_vimp
    s_add_u32 s73, s73, 6
    s_cmp_le_u32 s72, s73
    s_cbranch_scc0 L_h_vimp
    s_sub_i32 s74, 256, s75
    s_ashr_i32 s74, s74, 5
    s_max_i32 s74, s74, 2
    s_min_i32 s74, s74, 7
    s_sub_i32 s29, 256, s72
    s_min_i32 s74, s74, s29
    s_cmp_le_i32 s74, 0
    s_cbranch_scc1 L_h_vimp
    s_mov_b32 s95, s74
    s_mov_b32 s91, 1
    s_mov_b32 s75, s74
    s_atomic_add s75, s[78:79], 0xc glc
L_h_vimp:
    s_lshl_b32 s28, s31, 3
    s_bfm_b64 exec, s28, 0
    s_waitcnt vmcnt(0)
    ds_write_b128 v51, v[24:27] offset:12544
    s_bfm_b64 exec, s31, 0
    s_add_u32 s29, s94, 768
    v_add_u32 v49, s29, v3
    v_lshlrev_b32 v50, 2, v3
    v_add_u32 v50, s30, v50
    ds_write_b32 v50, v49
    s_mov_b64 exec, 1
    s_cmp_lg_u32 s91, 0
    s_cbranch_scc0 L_h_vnext
    s_waitcnt lgkmcnt(0)
    s_branch L_h_vhave
L_h_vnext:
    s_cmp_lt_u32 s75, 256
    s_cbranch_scc1 L_h_vloop
L_h_vstop:
    s_mov_b64 exec, 0xff
    s_lshl_b32 s30, s72, 2
    s_add_u32 s30, s30, 10496
    v_lshlrev_b32 v48, 2, v3
    v_add_u32 v48, s30, v48
    v_mov_b32 v49, 1024
    ds_write_b32 v48, v49
    s_mov_b64 exec, 1
    s_waitcnt lgkmcnt(0)
    s_endpgm
.section .rodata,"a"
.p2align 6
.amdhsa_kernel standalone__softmax_full_bidir__decode_kernel
  .amdhsa_next_free_vgpr 148
  .amdhsa_next_free_sgpr 96
  .amdhsa_accum_offset 148
  .amdhsa_group_segment_fixed_size 0
  .amdhsa_kernarg_size 48
  .amdhsa_user_sgpr_count 2
  .amdhsa_user_sgpr_kernarg_segment_ptr 1
  .amdhsa_system_sgpr_workgroup_id_x 1
.end_amdhsa_kernel
```
